```python
import torch

def _softmax(x, axis=-1):
    return torch.softmax(x, dim=axis)
def _gelu(x):
    return torch.nn.functional.gelu(x, approximate="tanh")
def _silu(x):
    return torch.nn.functional.silu(x)
def _sigmoid(x):
    return torch.sigmoid(x)
def _layernorm(x, axis=-1, eps=1e-5):
    m = x.mean(dim=axis, keepdim=True)
    v = x.var(dim=axis, keepdim=True, unbiased=False)
    return (x - m) / torch.sqrt(v + eps)
def _scatter_add(tgt, idx, src, axis=0):
    return tgt.clone().index_add_(axis, idx, src)
def _segment_sum(src, seg, n):
    out = torch.zeros((n,) + src.shape[1:], dtype=src.dtype)
    return out.index_add_(0, seg, src)
def _pad(x, pw):
    flat = tuple(v for pair in reversed(pw) for v in pair)
    return torch.nn.functional.pad(x, flat)

kernel_name = 'standalone__spectral_fnet__prompt'

def setup_inputs():

    _w = (lambda a: (lambda t: t.to(torch.bfloat16) if t.is_floating_point() else t)(torch.as_tensor(a)))
    B, S, D = 1, 2048, 512
    ns = torch.arange(S)[:, None] * torch.arange(S)[None, :]
    nd = torch.arange(D)[:, None] * torch.arange(D)[None, :]
    Ws_re = torch.cos(-2.0 * torch.pi * ns / S).to(float)
    Ws_im = torch.sin(-2.0 * torch.pi * ns / S).to(float)
    Wd_re = torch.cos(-2.0 * torch.pi * nd / D).to(float)
    Wd_im = torch.sin(-2.0 * torch.pi * nd / D).to(float)
    return {
        "x": _w((lambda *s: torch.randn(*s, dtype=torch.bfloat16) * 0.05)(B, S, D)),
        "dft_seq_re": _w(Ws_re),
        "dft_seq_im": _w(Ws_im),
        "dft_hid_re": _w(Wd_re),
        "dft_hid_im": _w(Wd_im),
    }

def reference(x, dft_seq_re, dft_seq_im, dft_hid_re, dft_hid_im):
    a = torch.einsum("bsd,ed->bse", x, dft_hid_re)
    b = torch.einsum("bsd,ed->bse", x, dft_hid_im)
    y = torch.einsum("ts,bse->bte", dft_seq_re, a) - torch.einsum("ts,bse->bte", dft_seq_im, b)
    return y
```

```asm
; @launch grid=(256,1,1) block=(256,1,1) lds=18464
.amdgcn_target "amdgcn-amd-amdhsa--gfx950"
.text
.globl standalone__spectral_fnet__prompt_kernel
.p2align 8
.type standalone__spectral_fnet__prompt_kernel,@function
standalone__spectral_fnet__prompt_kernel:
    s_load_dwordx2 s[8:9], s[0:1], 0
    s_load_dwordx2 s[12:13], s[0:1], 56
    s_load_dwordx2 s[40:41], s[0:1], 40
    s_cmp_ge_u32 s2, 256
    s_cbranch_scc1 L_end
    s_and_b32 s18, s2, 7
    s_sub_u32 s19, 16, s18
    s_min_u32 s21, s18, 1
    s_cselect_b32 s19, 8, s19
    s_bitcmp1_b32 s2, 3
    s_cselect_b32 s16, s19, s18
    s_lshr_b32 s17, s2, 4
    v_lshrrev_b32 v4, 1, v0
    v_lshl_add_u32 v5, v4, 4, s16
    v_and_b32 v6, 1, v0
    v_lshlrev_b32 v6, 4, v6
    v_lshrrev_b32 v3, 6, v0
    v_lshl_add_u32 v4, v5, 10, v6
    v_sub_u32 v5, 0, v5
    v_readfirstlane_b32 s20, v3
    v_and_b32 v5, 2047, v5
    v_lshl_add_u32 v5, v5, 10, v6
    s_lshl_b32 s18, s17, 5
    s_sub_u32 s19, 992, s18
    s_lshl_b32 m0, s20, 10
    s_bitcmp1_b32 s2, 4
    s_cbranch_scc0 L_ns
    v_swap_b32 v4, v5
    s_mov_b32 s21, s18
    s_mov_b32 s18, s19
    s_mov_b32 s19, s21
    s_or_b32 m0, m0, 4096
L_ns:
    v_bfe_u32 v8, v0, 3, 3
    v_lshl_add_u32 v8, v3, 4, v8
    v_and_b32 v9, 7, v0
    v_mul_u32_u24 v96, 33024, v8
    v_lshl_add_u32 v96, v9, 4, v96
    v_mul_u32_u24 v159, 80, v8
    v_lshl_add_u32 v158, v9, 2, v159
    v_add_u32 v158, 13344, v158
    s_mul_i32 s22, s16, 2048
    s_lshl_b32 s23, s17, 7
    s_add_u32 s22, s22, s23
    s_add_u32 s23, s22, 264192
    s_mov_b32 s14, 2113664
    s_mov_b32 s15, 0x20000
    s_mov_b32 s10, 2097152
    s_mov_b32 s11, 0x20000
    s_waitcnt lgkmcnt(0)
    buffer_load_dwordx4 v4, s[8:11], s18 offen nt lds
    s_xor_b32 m0, m0, 4096
    s_nop 0
    buffer_load_dwordx4 v5, s[8:11], s19 offen nt lds
    s_add_u32 s44, s12, 2113536
    s_addc_u32 s45, s13, 0
    s_load_dword s73, s[44:45], 0
    v_and_b32 v1, 15, v0
    v_bfe_u32 v2, v0, 4, 2
    v_lshl_add_u32 v7, v3, 4, v1
    v_cmp_eq_u32 vcc, 0, v7
    v_cvt_f32_u32 v8, v7
    v_cvt_f32_u32 v157, v2
    v_mul_f32 v8, 0x3c000000, v8
    v_mul_f32 v157, 4.0, v157
    v_cndmask_b32 v10, v8, 0.5, vcc
    v_mov_b32 v11, 0x3e800000
    v_cndmask_b32 v11, v11, 0, vcc
    v_mul_f32 v12, v8, v157
    v_fma_f32 v13, v10, v157, v11
    v_cos_f32 v16, v12
    v_cos_f32 v24, v13
    v_add_f32 v12, v12, v8
    v_add_f32 v13, v13, v10
    v_cos_f32 v17, v12
    v_cos_f32 v25, v13
    v_add_f32 v12, v12, v8
    v_add_f32 v13, v13, v10
    v_cos_f32 v18, v12
    v_cos_f32 v26, v13
    v_add_f32 v12, v12, v8
    v_add_f32 v13, v13, v10
    v_cos_f32 v19, v12
    v_cos_f32 v27, v13
    v_fmamk_f32 v12, v8, 0x41500000, v12
    v_fmamk_f32 v13, v10, 0x41500000, v13
    v_cos_f32 v20, v12
    v_cos_f32 v28, v13
    v_add_f32 v12, v12, v8
    v_add_f32 v13, v13, v10
    v_cos_f32 v21, v12
    v_cos_f32 v29, v13
    v_add_f32 v12, v12, v8
    v_add_f32 v13, v13, v10
    v_cos_f32 v22, v12
    v_cos_f32 v30, v13
    v_add_f32 v12, v12, v8
    v_add_f32 v13, v13, v10
    v_cos_f32 v23, v12
    v_cos_f32 v31, v13
    v_and_b32 v14, 1, v0
    v_cmp_eq_u32 vcc, 1, v14
    s_mov_b32 s21, 0x80008000
    v_mul_lo_u32 v14, v14, s21
    v_bfe_u32 v15, v0, 1, 1
    v_mul_lo_u32 v15, v15, s21
    v_xor_b32 v12, v14, v15
    v_cvt_pk_bf16_f32 v32, v16, v17
    v_cvt_pk_bf16_f32 v36, v24, v25
    v_cvt_pk_bf16_f32 v33, v18, v19
    v_cvt_pk_bf16_f32 v37, v26, v27
    v_cvt_pk_bf16_f32 v34, v20, v21
    v_cvt_pk_bf16_f32 v38, v28, v29
    v_cvt_pk_bf16_f32 v35, v22, v23
    v_cvt_pk_bf16_f32 v39, v30, v31
    v_cndmask_b32 v40, v32, v36, vcc
    v_cndmask_b32 v44, v36, v32, vcc
    v_cndmask_b32 v41, v33, v37, vcc
    v_cndmask_b32 v45, v37, v33, vcc
    v_cndmask_b32 v42, v34, v38, vcc
    v_cndmask_b32 v46, v38, v34, vcc
    v_cndmask_b32 v43, v35, v39, vcc
    v_cndmask_b32 v47, v39, v35, vcc
    v_xor_b32 v40, v40, v15
    v_xor_b32 v44, v44, v12
    v_xor_b32 v41, v41, v15
    v_xor_b32 v45, v45, v12
    v_xor_b32 v42, v42, v15
    v_xor_b32 v46, v46, v12
    v_xor_b32 v43, v43, v15
    v_xor_b32 v47, v47, v12
    v_xor_b32 v48, v32, v14
    v_xor_b32 v49, v33, v14
    v_xor_b32 v50, v34, v14
    v_xor_b32 v51, v35, v14
    v_xor_b32 v52, v36, v14
    v_xor_b32 v53, v37, v14
    v_xor_b32 v54, v38, v14
    v_xor_b32 v55, v39, v14
    v_xor_b32 v56, v40, v14
    v_xor_b32 v57, v41, v14
    v_xor_b32 v58, v42, v14
    v_xor_b32 v59, v43, v14
    v_xor_b32 v60, v44, v14
    v_xor_b32 v61, v45, v14
    v_xor_b32 v62, v46, v14
    v_xor_b32 v63, v47, v14
    v_and_b32 v5, 63, v0
    v_lshlrev_b32 v5, 3, v5
    v_xor_b32 v6, 24, v5
    v_mul_u32_u24 v7, 80, v7
    v_mov_b32 v180, 0
    v_mov_b32 v181, 0
    v_mov_b32 v182, 0
    v_mov_b32 v183, 0
    v_lshl_add_u32 v7, v2, 4, v7
    s_and_b32 s28, s2, 7
    s_lshr_b32 s31, s2, 5
    s_lshl_b32 s31, s31, 3
    s_or_b32 s28, s28, s31
    s_bfe_u32 s29, s2, 0x20003
    s_mul_i32 s68, s28, 33024
    s_add_u32 s69, s68, 4096
    v_mul_u32_u24 v152, 8192, v2
    v_lshl_add_u32 v152, v3, 9, v152
    v_and_b32 v8, 8, v1
    v_add_u32 v8, v8, v1
    v_lshl_add_u32 v152, v8, 4, v152
    s_mov_b32 s24, s40
    s_and_b32 s25, s41, 0xffff
    s_mov_b32 s26, 2097152
    s_mov_b32 s27, 0x20000
    s_lshl_b32 s30, s29, 9
    s_add_u32 s30, s30, s28
    s_cmp_eq_u32 s28, 0
    s_cselect_b32 s35, 0, 1.0
    s_cselect_b32 s31, s29, 0
    s_cmp_ge_u32 s31, 2
    s_cselect_b32 s34, 0, 1.0
    s_cselect_b32 s35, 1.0, s35
    s_cselect_b32 s38, 0, 0xbe800000
    s_cselect_b32 s31, 960, 0
    s_sub_u32 s30, s30, s31
    s_cmp_eq_u32 s2, 0
    s_cselect_b32 s70, 0x10101010, 0
    s_mov_b32 s71, s70
    v_and_b32 v8, 3, v1
    v_lshl_add_u32 v8, v8, 7, s30
    v_cvt_f32_u32 v8, v8
    v_mul_f32 v8, 0x3a000000, v8
    v_and_b32 v9, 4, v1
    v_cvt_f32_u32 v9, v9
    v_mul_f32 v9, 0x3d800000, v9
    v_cndmask_b32 v8, v8, 0.5, s[70:71]
    v_cndmask_b32 v9, v9, 0, s[70:71]
    v_fma_f32 v11, v8, v157, v9
    v_add_f32 v12, s38, v11
    s_mov_b32 s70, 0xff00ff00
    s_mov_b32 s71, s70
    v_cos_f32 v16, v11
    v_cos_f32 v17, v12
    v_add_f32 v11, v11, v8
    v_add_f32 v12, v12, v8
    v_cos_f32 v18, v11
    v_cos_f32 v19, v12
    v_add_f32 v11, v11, v8
    v_add_f32 v12, v12, v8
    v_cos_f32 v20, v11
    v_cos_f32 v21, v12
    v_add_f32 v11, v11, v8
    v_add_f32 v12, v12, v8
    v_cos_f32 v22, v11
    v_cos_f32 v23, v12
    v_pk_mul_f32 v[16:17], s[34:35], v[16:17]
    v_pk_mul_f32 v[18:19], s[34:35], v[18:19]
    v_pk_mul_f32 v[20:21], s[34:35], v[20:21]
    v_pk_mul_f32 v[22:23], s[34:35], v[22:23]
    v_cvt_pk_bf16_f32 v100, v16, v17
    v_cvt_pk_bf16_f32 v101, v18, v19
    v_cvt_pk_bf16_f32 v102, v20, v21
    v_cvt_pk_bf16_f32 v103, v22, v23
    v_cndmask_b32 v192, v100, 0, s[70:71]
    v_cndmask_b32 v193, 0, v100, s[70:71]
    v_cndmask_b32 v194, v101, 0, s[70:71]
    v_cndmask_b32 v195, 0, v101, s[70:71]
    v_cndmask_b32 v196, v102, 0, s[70:71]
    v_cndmask_b32 v197, 0, v102, s[70:71]
    v_cndmask_b32 v198, v103, 0, s[70:71]
    v_cndmask_b32 v199, 0, v103, s[70:71]
    v_and_b32 v9, 1, v2
    s_waitcnt lgkmcnt(0)
    s_add_u32 s72, s73, 0x9e3779b9
    s_or_b32 s72, s72, 1
    v_mov_b32 v145, s72
    v_mov_b32 v149, s72
    v_mov_b32 v185, s72
    v_mov_b32 v189, s72
    s_waitcnt vmcnt(0)
    s_barrier
    ds_read_b64_tr_b16 v[68:69], v6 offset:4096
    ds_read_b64_tr_b16 v[70:71], v6 offset:4608
    ds_read_b64_tr_b16 v[76:77], v6 offset:5120
    ds_read_b64_tr_b16 v[78:79], v6 offset:5632
    ds_read_b64_tr_b16 v[84:85], v6 offset:6144
    ds_read_b64_tr_b16 v[86:87], v6 offset:6656
    ds_read_b64_tr_b16 v[92:93], v6 offset:7168
    ds_read_b64_tr_b16 v[94:95], v6 offset:7680
    ds_read_b64_tr_b16 v[64:65], v5 offset:0
    ds_read_b64_tr_b16 v[66:67], v5 offset:512
    ds_read_b64_tr_b16 v[72:73], v5 offset:1024
    ds_read_b64_tr_b16 v[74:75], v5 offset:1536
    ds_read_b64_tr_b16 v[80:81], v5 offset:2048
    ds_read_b64_tr_b16 v[82:83], v5 offset:2560
    ds_read_b64_tr_b16 v[88:89], v5 offset:3072
    ds_read_b64_tr_b16 v[90:91], v5 offset:3584
    s_waitcnt lgkmcnt(14)
    v_mfma_f32_16x16x32_bf16 v[24:27], v[68:71], v[32:35], 0
    v_mfma_f32_16x16x32_bf16 v[28:31], v[68:71], v[36:39], 0
    s_waitcnt lgkmcnt(12)
    v_mfma_f32_16x16x32_bf16 v[24:27], v[76:79], v[40:43], v[24:27]
    v_mfma_f32_16x16x32_bf16 v[28:31], v[76:79], v[44:47], v[28:31]
    s_waitcnt lgkmcnt(10)
    v_mfma_f32_16x16x32_bf16 v[24:27], v[84:87], v[48:51], v[24:27]
    v_mfma_f32_16x16x32_bf16 v[28:31], v[84:87], v[52:55], v[28:31]
    s_waitcnt lgkmcnt(8)
    v_mfma_f32_16x16x32_bf16 v[24:27], v[92:95], v[56:59], v[24:27]
    v_mfma_f32_16x16x32_bf16 v[28:31], v[92:95], v[60:63], v[28:31]
    s_waitcnt lgkmcnt(6)
    v_mfma_f32_16x16x32_bf16 v[16:19], v[64:67], v[32:35], 0
    v_mfma_f32_16x16x32_bf16 v[20:23], v[64:67], v[36:39], 0
    s_waitcnt lgkmcnt(4)
    v_mfma_f32_16x16x32_bf16 v[16:19], v[72:75], v[40:43], v[16:19]
    s_waitcnt lgkmcnt(2)
    v_mfma_f32_16x16x32_bf16 v[16:19], v[80:83], v[48:51], v[16:19]
    s_nop 0
    v_cvt_pk_bf16_f32 v68, v24, v28
    s_waitcnt lgkmcnt(0)
    v_mfma_f32_16x16x32_bf16 v[16:19], v[88:91], v[56:59], v[16:19]
    v_permlane16_swap_b32 v180, v24
    v_permlane16_swap_b32 v181, v28
    v_mfma_f32_16x16x32_bf16 v[20:23], v[72:75], v[44:47], v[20:23]
    v_permlane32_swap_b32 v182, v24
    v_permlane32_swap_b32 v183, v28
    v_mfma_f32_16x16x32_bf16 v[20:23], v[80:83], v[52:55], v[20:23]
    v_permlane16_swap_b32 v182, v180
    v_permlane16_swap_b32 v183, v181
    v_mfma_f32_16x16x32_bf16 v[20:23], v[88:91], v[60:63], v[20:23]
    ds_write_b32 v7, v68 offset:13360
    v_add_f32 v17, v17, v27
    v_add_f32 v18, v18, v26
    v_add_f32 v19, v19, v25
    v_add_f32 v16, v16, v180
    v_lshrrev_b32 v13, 1, v2
    v_lshrrev_b32 v8, 5, v0
    v_and_b32 v10, 7, v1
    v_add_f32 v21, v21, v31
    v_add_f32 v22, v22, v30
    v_add_f32 v23, v23, v29
    v_add_f32 v20, v20, v181
    v_cvt_pk_bf16_f32 v69, v17, v21
    v_cvt_pk_bf16_f32 v70, v18, v22
    v_cvt_pk_bf16_f32 v71, v19, v23
    v_cvt_pk_bf16_f32 v68, v16, v20
    ds_write_b128 v7, v[68:71] offset:13344
    ds_read2_b32 v[146:147], v158 offset1:8
    s_bitcmp1_b32 s16, 0
    s_cbranch_scc1 L_odd
    ds_read_b32 v144, v159 offset:13408
    ds_read2_b32 v[186:187], v158 offset0:160 offset1:168
    ds_read_b32 v184, v159 offset:14048
    s_waitcnt lgkmcnt(2)
    buffer_store_dwordx4 v[144:147], v96, s[12:15], s22 offen sc1
    s_waitcnt lgkmcnt(0)
    buffer_store_dwordx4 v[184:187], v96, s[12:15], s23 offen sc1
    s_branch L_join
L_odd:
    ds_read_b32 v148, v159 offset:13408
    ds_read2_b32 v[186:187], v158 offset0:160 offset1:168
    ds_read_b32 v188, v159 offset:14048
    s_waitcnt lgkmcnt(2)
    buffer_store_dwordx4 v[146:149], v96, s[12:15], s22 offen sc1
    s_waitcnt lgkmcnt(0)
    buffer_store_dwordx4 v[186:189], v96, s[12:15], s23 offen sc1
L_join:
    v_and_b32 v11, 8, v1
    v_mul_u32_u24 v97, 544, v10
    v_lshl_add_u32 v97, v8, 6, v97
    v_lshl_add_u32 v97, v11, 1, v97
    v_lshl_add_u32 v97, v9, 3, v97
    v_lshlrev_b32 v154, 5, v10
    v_lshl_add_u32 v154, v8, 2, v154
    v_lshl_add_u32 v8, v9, 2, v3
    v_mul_u32_u24 v98, 544, v8
    v_lshl_add_u32 v98, v13, 8, v98
    v_lshl_add_u32 v98, v1, 3, v98
    v_lshlrev_b32 v155, 5, v8
    v_lshl_add_u32 v155, v13, 4, v155
    v_add_u32 v155, 13088, v155
    v_lshl_add_u32 v8, v1, 2, v2
    v_lshlrev_b32 v99, 4, v8
    v_sub_u32 v153, 1008, v99
    v_add_u32 v8, 1, v8
    v_and_b32 v10, 3, v8
    v_and_b32 v8, 60, v8
    v_lshl_add_u32 v156, v10, 6, v8
    s_lshl_b32 s31, s20, 7
    s_add_u32 s31, s31, s30
    s_lshl_b32 s36, s31, 10
    s_sub_u32 s37, 0, s36
    s_and_b32 s37, s37, 0x1fffff
    s_or_b32 s46, s2, s20
    s_cbranch_scc1 L_nsp
    v_mov_b32 v10, 0
    v_mov_b32 v11, 0
    ds_write_b64 v5, v[10:11] offset:12544
    s_mov_b32 exec_lo, 0xffff0000
    s_mov_b32 exec_hi, 0xffff0000
    v_add_u32 v98, 2176, v98
    v_mov_b32 v155, 12544
    s_mov_b64 exec, -1
L_nsp:
    v_and_b32 v8, 12, v1
    v_add_u32 v8, v8, v1
    v_cvt_f32_u32 v14, v8
    v_add_f32 v15, 4.0, v14
    v_cvt_f32_u32 v13, v13
    v_mul_f32 v13, 0x41000000, v13
    v_cvt_f32_u32 v9, v9
    v_mul_f32 v9, 0x3e800000, v9
    v_mul_f32 v8, 0xbd000000, v14
    v_fma_f32 v11, v8, v13, v9
    v_cos_f32 v16, v11
    v_sin_f32 v24, v11
    v_add_f32 v11, v11, v8
    v_cos_f32 v17, v11
    v_sin_f32 v25, v11
    v_add_f32 v11, v11, v8
    v_cos_f32 v18, v11
    v_sin_f32 v26, v11
    v_add_f32 v11, v11, v8
    v_cos_f32 v19, v11
    v_sin_f32 v27, v11
    v_add_f32 v11, v11, v8
    v_cos_f32 v20, v11
    v_sin_f32 v28, v11
    v_add_f32 v11, v11, v8
    v_cos_f32 v21, v11
    v_sin_f32 v29, v11
    v_add_f32 v11, v11, v8
    v_cos_f32 v22, v11
    v_sin_f32 v30, v11
    v_add_f32 v11, v11, v8
    v_cos_f32 v23, v11
    v_sin_f32 v31, v11
    v_add_f32 v11, v11, v8
    v_cos_f32 v12, v11
    v_cvt_pk_bf16_f32 v104, v16, v17
    v_cvt_pk_bf16_f32 v108, v24, v25
    v_cvt_pk_bf16_f32 v140, v17, v18
    v_cvt_pk_bf16_f32 v105, v18, v19
    v_cvt_pk_bf16_f32 v109, v26, v27
    v_cvt_pk_bf16_f32 v141, v19, v20
    v_cvt_pk_bf16_f32 v106, v20, v21
    v_cvt_pk_bf16_f32 v110, v28, v29
    v_cvt_pk_bf16_f32 v142, v21, v22
    v_cvt_pk_bf16_f32 v107, v22, v23
    v_cvt_pk_bf16_f32 v111, v30, v31
    v_cvt_pk_bf16_f32 v143, v23, v12
    v_mul_f32 v8, 0xbd000000, v15
    v_fma_f32 v11, v8, v13, v9
    v_cos_f32 v16, v11
    v_sin_f32 v24, v11
    v_add_f32 v11, v11, v8
    v_cos_f32 v17, v11
    v_sin_f32 v25, v11
    v_add_f32 v11, v11, v8
    v_cos_f32 v18, v11
    v_sin_f32 v26, v11
    v_add_f32 v11, v11, v8
    v_cos_f32 v19, v11
    v_sin_f32 v27, v11
    v_add_f32 v11, v11, v8
    v_cos_f32 v20, v11
    v_sin_f32 v28, v11
    v_add_f32 v11, v11, v8
    v_cos_f32 v21, v11
    v_sin_f32 v29, v11
    v_add_f32 v11, v11, v8
    v_cos_f32 v22, v11
    v_sin_f32 v30, v11
    v_add_f32 v11, v11, v8
    v_cos_f32 v23, v11
    v_sin_f32 v31, v11
    v_add_f32 v11, v11, v8
    v_cos_f32 v12, v11
    v_cvt_pk_bf16_f32 v112, v16, v17
    v_cvt_pk_bf16_f32 v116, v24, v25
    v_cvt_pk_bf16_f32 v176, v17, v18
    v_cvt_pk_bf16_f32 v113, v18, v19
    v_cvt_pk_bf16_f32 v117, v26, v27
    v_cvt_pk_bf16_f32 v177, v19, v20
    v_cvt_pk_bf16_f32 v114, v20, v21
    v_cvt_pk_bf16_f32 v118, v28, v29
    v_cvt_pk_bf16_f32 v178, v21, v22
    v_cvt_pk_bf16_f32 v115, v22, v23
    v_cvt_pk_bf16_f32 v119, v30, v31
    v_cvt_pk_bf16_f32 v179, v23, v12
    v_mul_f32 v8, 0x3b000000, v14
    v_mul_f32 v9, 0x3b000000, v15
    v_mul_f32 v11, v8, v157
    v_mul_f32 v12, v9, v157
    v_cos_f32 v120, v11
    v_sin_f32 v128, v11
    v_cos_f32 v124, v12
    v_sin_f32 v132, v12
    v_add_f32 v11, v11, v8
    v_add_f32 v12, v12, v9
    v_cos_f32 v121, v11
    v_sin_f32 v129, v11
    v_cos_f32 v125, v12
    v_sin_f32 v133, v12
    v_add_f32 v11, v11, v8
    v_add_f32 v12, v12, v9
    v_cos_f32 v122, v11
    v_sin_f32 v130, v11
    v_cos_f32 v126, v12
    v_sin_f32 v134, v12
    v_add_f32 v11, v11, v8
    v_add_f32 v12, v12, v9
    v_cos_f32 v123, v11
    v_sin_f32 v131, v11
    v_cos_f32 v127, v12
    v_sin_f32 v135, v12
    v_cvt_f32_u32 v8, v1
    v_mul_f32 v8, 0x3d800000, v8
    v_mul_f32 v11, v8, v157
    v_cos_f32 v16, v11
    v_sin_f32 v20, v11
    v_add_f32 v11, v11, v8
    v_cos_f32 v17, v11
    v_sin_f32 v21, v11
    v_add_f32 v11, v11, v8
    v_cos_f32 v18, v11
    v_sin_f32 v22, v11
    v_add_f32 v11, v11, v8
    v_cos_f32 v19, v11
    v_sin_f32 v23, v11
    v_cvt_pk_bf16_f32 v136, v16, v17
    v_cvt_pk_bf16_f32 v137, v18, v19
    v_cvt_pk_bf16_f32 v138, v20, v21
    v_cvt_pk_bf16_f32 v139, v22, v23
    s_mov_b32 vcc_lo, 0xaaaaaaaa
    s_mov_b32 vcc_hi, 0xaaaaaaaa
    s_mov_b32 s47, 0
L_retry:
    buffer_load_dwordx4 v[48:51], v152, s[12:15], s68 offen offset:0 sc1
    buffer_load_dwordx4 v[52:55], v152, s[12:15], s68 offen offset:2048 sc1
    buffer_load_dwordx4 v[56:59], v152, s[12:15], s69 offen offset:0 sc1
    buffer_load_dwordx4 v[60:63], v152, s[12:15], s69 offen offset:2048 sc1
    buffer_load_dwordx4 v[64:67], v152, s[12:15], s68 offen offset:128 sc1
    buffer_load_dwordx4 v[68:71], v152, s[12:15], s68 offen offset:2176 sc1
    buffer_load_dwordx4 v[72:75], v152, s[12:15], s69 offen offset:128 sc1
    buffer_load_dwordx4 v[76:79], v152, s[12:15], s69 offen offset:2176 sc1
    s_mov_b64 exec, -1
    s_add_u32 s47, s47, 1
    s_cmp_lt_u32 s47, 0x4000
    s_cselect_b64 s[74:75], -1, 0
    s_waitcnt vmcnt(6)
    v_mfma_f32_16x16x32_bf16 v[16:19], v[50:53], v[192:195], 0
    v_bitop3_b32 v8, v49, v55, s72 bitop3:0x7e
    s_waitcnt vmcnt(4)
    v_mfma_f32_16x16x32_bf16 v[16:19], v[58:61], v[196:199], v[16:19]
    v_bitop3_b32 v9, v57, v63, s72 bitop3:0x7e
    s_waitcnt vmcnt(2)
    v_mfma_f32_16x16x32_bf16 v[20:23], v[66:69], v[192:195], 0
    v_cndmask_b32 v80, v48, v64, vcc
    v_cndmask_b32 v81, v54, v70, vcc
    v_bitop3_b32 v10, v65, v71, s72 bitop3:0x7e
    v_or3_b32 v8, v8, v9, v10
    s_waitcnt vmcnt(0)
    v_mfma_f32_16x16x32_bf16 v[20:23], v[74:77], v[196:199], v[20:23]
    v_cndmask_b32 v82, v56, v72, vcc
    v_cndmask_b32 v83, v62, v78, vcc
    v_bitop3_b32 v9, v73, v79, s72 bitop3:0x7e
    v_or_b32 v8, v8, v9
    v_mfma_f32_16x16x32_bf16 v[24:27], v[80:83], v[100:103], 0
    v_cmp_ne_u32 s[76:77], 0, v8
    v_cvt_pk_bf16_f32 v84, v16, v17
    v_cvt_pk_bf16_f32 v85, v18, v19
    s_and_b64 exec, s[76:77], s[74:75]
    s_cbranch_scc1 L_retry
    s_mov_b64 exec, -1
    ds_write_b64 v97, v[84:85] offset:8192
    v_cvt_pk_bf16_f32 v86, v20, v21
    v_cvt_pk_bf16_f32 v87, v22, v23
    v_cvt_pk_bf16_f32 v88, v24, v25
    ds_write_b64 v97, v[86:87] offset:8224
    ds_write_b32 v154, v88 offset:13088
    s_waitcnt lgkmcnt(0)
    s_barrier
L_cd:
    ds_read_b64_tr_b16 v[64:65], v98 offset:8192
    ds_read_b64_tr_b16 v[66:67], v98 offset:8320
    ds_read_b128 v[72:75], v155
    s_waitcnt lgkmcnt(1)
    v_mfma_f32_16x16x32_bf16 v[16:19], v[64:67], v[104:107], 0
    v_mfma_f32_16x16x32_bf16 v[20:23], v[64:67], v[108:111], 0
    v_mfma_f32_16x16x32_bf16 v[24:27], v[64:67], v[112:115], 0
    v_mfma_f32_16x16x32_bf16 v[28:31], v[64:67], v[116:119], 0
    s_waitcnt lgkmcnt(0)
    v_mfma_f32_16x16x32_bf16 v[160:163], v[140:143], v[72:75], 0
    v_mfma_f32_16x16x32_bf16 v[164:167], v[176:179], v[72:75], 0
    s_nop 1
    v_mul_f32 v48, v16, v120
    v_mul_f32 v49, v17, v121
    v_mul_f32 v50, v18, v122
    v_mul_f32 v51, v19, v123
    v_pk_mul_f32 v[52:53], v[20:21], v[120:121]
    v_pk_mul_f32 v[54:55], v[22:23], v[122:123]
    v_pk_fma_f32 v[48:49], v[20:21], v[128:129], v[48:49]
    v_pk_fma_f32 v[50:51], v[22:23], v[130:131], v[50:51]
    v_pk_fma_f32 v[52:53], v[16:17], v[128:129], v[52:53] neg_lo:[1,0,0] neg_hi:[1,0,0]
    v_pk_fma_f32 v[54:55], v[18:19], v[130:131], v[54:55] neg_lo:[1,0,0] neg_hi:[1,0,0]
    v_pk_mul_f32 v[56:57], v[24:25], v[124:125]
    v_pk_mul_f32 v[58:59], v[26:27], v[126:127]
    v_pk_mul_f32 v[60:61], v[28:29], v[124:125]
    v_pk_mul_f32 v[62:63], v[30:31], v[126:127]
    v_pk_fma_f32 v[56:57], v[28:29], v[132:133], v[56:57]
    v_pk_fma_f32 v[58:59], v[30:31], v[134:135], v[58:59]
    v_pk_fma_f32 v[60:61], v[24:25], v[132:133], v[60:61] neg_lo:[1,0,0] neg_hi:[1,0,0]
    v_pk_fma_f32 v[62:63], v[26:27], v[134:135], v[62:63] neg_lo:[1,0,0] neg_hi:[1,0,0]
    v_cvt_pk_bf16_f32 v80, v48, v49
    v_cvt_pk_bf16_f32 v81, v50, v51
    v_cvt_pk_bf16_f32 v82, v52, v53
    v_cvt_pk_bf16_f32 v83, v54, v55
    v_cvt_pk_bf16_f32 v84, v56, v57
    v_cvt_pk_bf16_f32 v85, v58, v59
    v_mfma_f32_16x16x32_bf16 v[160:163], v[80:83], v[136:139], v[160:163]
    v_cvt_pk_bf16_f32 v86, v60, v61
    v_cvt_pk_bf16_f32 v87, v62, v63
    s_nop 1
    v_mfma_f32_16x16x32_bf16 v[164:167], v[84:87], v[136:139], v[164:167]
    s_nop 2
    ds_bpermute_b32 v168, v156, v160
    v_cvt_pk_bf16_f32 v8, v160, v161
    v_cvt_pk_bf16_f32 v9, v162, v163
    v_cvt_pk_bf16_f32 v15, v162, v161
    s_nop 0
    v_cvt_pk_bf16_f32 v10, v164, v165
    v_cvt_pk_bf16_f32 v11, v166, v167
    buffer_store_dwordx4 v[8:11], v99, s[24:27], s36 offen
    v_cvt_pk_bf16_f32 v13, v166, v165
    v_cvt_pk_bf16_f32 v14, v164, v163
    s_waitcnt lgkmcnt(0)
    v_cvt_pk_bf16_f32 v12, v168, v167
    buffer_store_dwordx4 v[12:15], v153, s[24:27], s37 offen
    s_cmp_lg_u32 s46, 0
    s_cbranch_scc1 L_nb
    s_mov_b32 s46, 1
    s_add_u32 s73, s73, 2
    v_mov_b32 v4, s73
    v_mov_b32 v5, 2113536
    s_mov_b64 exec, 1
    buffer_store_dword v4, v5, s[12:15], 0 offen
    s_mov_b32 exec_lo, 0xffff
    s_mov_b32 exec_hi, 0xffff
    v_add_u32 v98, 2176, v98
    v_add_u32 v155, 128, v155
    s_mov_b64 exec, -1
    s_mov_b32 s36, 0x100000
    s_mov_b32 s37, s36
    s_branch L_cd
L_nb:
L_end:
    s_endpgm
.fill 64, 4, 0xbf810000
.section .rodata,"a"
.p2align 6
.amdhsa_kernel standalone__spectral_fnet__prompt_kernel
  .amdhsa_next_free_vgpr 200
  .amdhsa_next_free_sgpr 80
  .amdhsa_accum_offset 200
  .amdhsa_group_segment_fixed_size 0
  .amdhsa_kernarg_size 64
  .amdhsa_user_sgpr_count 2
  .amdhsa_user_sgpr_kernarg_segment_ptr 1
  .amdhsa_system_sgpr_workgroup_id_x 1
.end_amdhsa_kernel
```
